```python
import torch

def _softmax(x, axis=-1):
    return torch.softmax(x, dim=axis)
def _gelu(x):
    return torch.nn.functional.gelu(x, approximate="tanh")
def _silu(x):
    return torch.nn.functional.silu(x)
def _sigmoid(x):
    return torch.sigmoid(x)
def _layernorm(x, axis=-1, eps=1e-5):
    m = x.mean(dim=axis, keepdim=True)
    v = x.var(dim=axis, keepdim=True, unbiased=False)
    return (x - m) / torch.sqrt(v + eps)
def _scatter_add(tgt, idx, src, axis=0):
    return tgt.clone().index_add_(axis, idx, src)
def _segment_sum(src, seg, n):
    out = torch.zeros((n,) + src.shape[1:], dtype=src.dtype)
    return out.index_add_(0, seg, src)
def _pad(x, pw):
    flat = tuple(v for pair in reversed(pw) for v in pair)
    return torch.nn.functional.pad(x, flat)

kernel_name = 'standalone__standard_2d_1d_3d_conv__vision'

def setup_inputs():

    _w = (lambda a: (lambda t: t.to(torch.bfloat16) if t.is_floating_point() else t)(torch.as_tensor(a)))
    H = W = 384
    C = 192
    K = 1
    return {
        "x": _w((lambda *s: torch.randn(*s, dtype=torch.bfloat16) * 0.05)(1, H, W, C)),
        "w": _w((lambda *s: torch.randn(*s, dtype=torch.bfloat16) * 0.05)(K, K, C, C)),
        "b": _w((lambda *s: torch.randn(*s, dtype=torch.bfloat16) * 0.05)(C)),
    }

def reference(x, w, b):
    B, H, W, Cin = x.shape
    K = w.shape[0]
    pl = (K - 1) // 2
    pr = K // 2
    xp = _pad(x, ((0, 0), (pl, pr), (pl, pr), (0, 0)))
    out = sum(
        torch.einsum('bhwc,cd->bhwd', xp[:, i:i+H, j:j+W, :], w[i, j])
        for i in range(K) for j in range(K)
    )
    return out + b[None, None, None, :]
```

```asm
; @launch grid=(256,1,1) block=(256,1,1) lds=159744
.amdgcn_target "amdgcn-amd-amdhsa--gfx950"
.text
.globl standalone__standard_2d_1d_3d_conv__vision_kernel
.p2align 8
.type standalone__standard_2d_1d_3d_conv__vision_kernel,@function
standalone__standard_2d_1d_3d_conv__vision_kernel:
  s_cmp_ge_u32 s2, 256
  s_cbranch_scc1 L_end
  s_load_dwordx8 s[4:11], s[0:1], 0
  s_load_dwordx2 s[46:47], s[0:1], 40
  v_lshrrev_b32 v1, 6, v0
  v_and_b32 v0, 63, v0
  v_readfirstlane_b32 s28, v1
  v_and_b32 v144, 15, v0
  v_lshrrev_b32 v145, 4, v0
  v_mul_u32_u24 v147, 3072, v145
  v_lshl_add_u32 v148, v144, 4, v147
  v_lshl_add_u32 v149, v144, 3, v147
  v_add_u32 v149, 256, v149
  v_lshlrev_b32 v150, 4, v144
  v_lshlrev_b32 v151, 3, v144
  v_mul_u32_u24 v153, 683, v0
  v_bfe_u32 v154, v153, 15, 3
  v_xor_b32 v154, v154, v0
  v_lshlrev_b32 v1, 4, v154
  v_add_u32 v153, 43712, v153
  v_bfe_u32 v154, v153, 15, 3
  v_xor_b32 v154, v154, v0
  v_lshlrev_b32 v2, 4, v154
  v_add_u32 v153, 43712, v153
  v_bfe_u32 v154, v153, 15, 3
  v_xor_b32 v154, v154, v0
  v_lshlrev_b32 v3, 4, v154
  v_xor_b32 v4, 64, v1
  v_xor_b32 v5, 0x1040, v2
  v_xor_b32 v6, 0x1040, v3
  s_lshl_b32 s30, s2, 2
  s_add_u32 s30, s30, s28
  s_mul_i32 s37, s30, 6144
  s_mul_i32 s38, s28, 30720
  s_mul_i32 s35, s28, 24576
  s_add_u32 s36, s35, 12288
  s_mov_b32 s14, 56623104
  s_mov_b32 s15, 0x00020000
  s_mov_b32 s18, 73728
  s_mov_b32 s19, s15
  s_mov_b32 s22, 384
  s_mov_b32 s23, s15
  s_lshr_b32 s3, s2, 6
  s_and_b32 s93, s3, 3
  s_lshl_b32 s93, s93, 3
  s_mov_b32 s74, 0xf0f7878
  s_cmp_eq_u32 s28, 3
  s_cselect_b32 s74, 0x17170f0f, s74
  s_lshr_b32 s74, s74, s93
  s_lshr_b32 s68, s2, 3
  s_lshl_b32 s68, s68, 21
  s_min_u32 s68, s68, 56623100
  s_cmp_eq_u32 s28, 3
  s_cbranch_scc1 L_w3
  s_bitcmp1_b32 s74, 0
  s_cbranch_scc0 L_wf
  s_waitcnt lgkmcnt(0)
  s_mov_b32 s12, s4
  s_and_b32 s13, s5, 0xffff
  s_cmp_eq_u32 s28, 0
  s_cselect_b64 s[70:71], s[4:5], s[10:11]
  s_cmp_eq_u32 s28, 2
  s_cbranch_scc1 L_tl0
  s_load_dword s72, s[70:71], s68
L_tl0:
  s_mov_b32 m0, s38
  s_add_u32 s40, s38, 4096
  buffer_load_dwordx4 v1, s[12:15], s37 offen nt lds
  buffer_load_dwordx4 v2, s[12:15], s37 offen offset:1024 nt lds
  buffer_load_dwordx4 v3, s[12:15], s37 offen offset:2048 nt lds
  buffer_load_dwordx4 v4, s[12:15], s37 offen offset:3072 nt lds
  s_mov_b32 m0, s40
  s_nop 0
  buffer_load_dwordx4 v5, s[12:15], s37 offen nt lds
  buffer_load_dwordx4 v6, s[12:15], s37 offen offset:1024 nt lds
  s_add_u32 s37, s37, 6291456
  s_add_u32 s38, s38, 6144
  s_mov_b32 m0, s38
  s_add_u32 s40, s38, 4096
  buffer_load_dwordx4 v1, s[12:15], s37 offen nt lds
  buffer_load_dwordx4 v2, s[12:15], s37 offen offset:1024 nt lds
  buffer_load_dwordx4 v3, s[12:15], s37 offen offset:2048 nt lds
  buffer_load_dwordx4 v4, s[12:15], s37 offen offset:3072 nt lds
  s_mov_b32 m0, s40
  s_nop 0
  buffer_load_dwordx4 v5, s[12:15], s37 offen nt lds
  buffer_load_dwordx4 v6, s[12:15], s37 offen offset:1024 nt lds
  s_add_u32 s37, s37, 6291456
  s_add_u32 s38, s38, 6144
  s_mov_b32 m0, s38
  s_add_u32 s40, s38, 4096
  buffer_load_dwordx4 v1, s[12:15], s37 offen nt lds
  buffer_load_dwordx4 v2, s[12:15], s37 offen offset:1024 nt lds
  buffer_load_dwordx4 v3, s[12:15], s37 offen offset:2048 nt lds
  buffer_load_dwordx4 v4, s[12:15], s37 offen offset:3072 nt lds
  s_mov_b32 m0, s40
  s_nop 0
  buffer_load_dwordx4 v5, s[12:15], s37 offen nt lds
  buffer_load_dwordx4 v6, s[12:15], s37 offen offset:1024 nt lds
  s_add_u32 s37, s37, 6291456
  s_add_u32 s38, s38, 6144
  s_branch L_wg
L_wf:
  s_waitcnt lgkmcnt(0)
  s_cmp_eq_u32 s28, 0
  s_cselect_b64 s[70:71], s[4:5], s[10:11]
  s_cmp_eq_u32 s28, 2
  s_cbranch_scc1 L_tl1
  s_load_dword s72, s[70:71], s68
L_tl1:
L_wg:
  s_mov_b32 s16, s6
  s_and_b32 s17, s7, 0xffff
  buffer_load_dwordx4 v[160:163], v148, s[16:19], s35 offen offset:0
  buffer_load_dwordx4 v[164:167], v148, s[16:19], s35 offen offset:384
  buffer_load_dwordx4 v[168:171], v148, s[16:19], s35 offen offset:768
  buffer_load_dwordx4 v[172:175], v148, s[16:19], s35 offen offset:1152
  buffer_load_dwordx4 v[176:179], v148, s[16:19], s35 offen offset:1536
  buffer_load_dwordx4 v[180:183], v148, s[16:19], s35 offen offset:1920
  buffer_load_dwordx4 v[184:187], v148, s[16:19], s35 offen offset:2304
  buffer_load_dwordx4 v[188:191], v148, s[16:19], s35 offen offset:2688
  buffer_load_dwordx2 v[192:193], v149, s[16:19], s35 offen offset:0
  buffer_load_dwordx2 v[194:195], v149, s[16:19], s35 offen offset:384
  buffer_load_dwordx2 v[196:197], v149, s[16:19], s35 offen offset:768
  buffer_load_dwordx2 v[198:199], v149, s[16:19], s35 offen offset:1152
  buffer_load_dwordx2 v[200:201], v149, s[16:19], s35 offen offset:1536
  buffer_load_dwordx2 v[202:203], v149, s[16:19], s35 offen offset:1920
  buffer_load_dwordx2 v[204:205], v149, s[16:19], s35 offen offset:2304
  buffer_load_dwordx2 v[206:207], v149, s[16:19], s35 offen offset:2688
  buffer_load_dwordx4 v[208:211], v148, s[16:19], s36 offen offset:0
  buffer_load_dwordx4 v[212:215], v148, s[16:19], s36 offen offset:384
  buffer_load_dwordx4 v[216:219], v148, s[16:19], s36 offen offset:768
  buffer_load_dwordx4 v[220:223], v148, s[16:19], s36 offen offset:1152
  buffer_load_dwordx4 v[224:227], v148, s[16:19], s36 offen offset:1536
  buffer_load_dwordx4 v[228:231], v148, s[16:19], s36 offen offset:1920
  buffer_load_dwordx4 v[232:235], v148, s[16:19], s36 offen offset:2304
  buffer_load_dwordx4 v[236:239], v148, s[16:19], s36 offen offset:2688
  buffer_load_dwordx2 v[240:241], v149, s[16:19], s36 offen offset:0
  buffer_load_dwordx2 v[242:243], v149, s[16:19], s36 offen offset:384
  buffer_load_dwordx2 v[244:245], v149, s[16:19], s36 offen offset:768
  buffer_load_dwordx2 v[246:247], v149, s[16:19], s36 offen offset:1152
  buffer_load_dwordx2 v[248:249], v149, s[16:19], s36 offen offset:1536
  buffer_load_dwordx2 v[250:251], v149, s[16:19], s36 offen offset:1920
  buffer_load_dwordx2 v[252:253], v149, s[16:19], s36 offen offset:2304
  buffer_load_dwordx2 v[254:255], v149, s[16:19], s36 offen offset:2688
  s_mov_b32 s12, s4
  s_and_b32 s13, s5, 0xffff
  s_mov_b32 s20, s8
  s_and_b32 s21, s9, 0xffff
  buffer_load_dwordx4 v[88:91], v150, s[20:23], 0 offen
  buffer_load_dwordx2 v[92:93], v151, s[20:23], 0 offen offset:256
  s_mov_b32 m0, s38
  s_add_u32 s40, s38, 4096
  buffer_load_dwordx4 v1, s[12:15], s37 offen nt lds
  buffer_load_dwordx4 v2, s[12:15], s37 offen offset:1024 nt lds
  buffer_load_dwordx4 v3, s[12:15], s37 offen offset:2048 nt lds
  buffer_load_dwordx4 v4, s[12:15], s37 offen offset:3072 nt lds
  s_mov_b32 m0, s40
  s_nop 0
  buffer_load_dwordx4 v5, s[12:15], s37 offen nt lds
  buffer_load_dwordx4 v6, s[12:15], s37 offen offset:1024 nt lds
  s_add_u32 s37, s37, 6291456
  s_add_u32 s38, s38, 6144
  s_mul_i32 s31, s30, 6144
  s_mul_i32 s32, s28, 30720
  s_add_u32 s43, s32, 30720
  s_mov_b32 s33, 0x05040100
  s_mov_b32 s34, 0x07060302
  s_mov_b32 s24, s10
  s_and_b32 s25, s11, 0xffff
  s_mov_b32 s26, 56623104
  s_mov_b32 s27, 0x00020000
  s_mov_b32 s48, s46
  s_and_b32 s49, s47, 0xffff
  s_mov_b32 s50, 2097152
  s_mov_b32 s51, 0x00020000
  s_mov_b32 s94, 268435456
  v_mov_b32 v14, s94
  v_cmp_eq_u32 vcc, 0, v0
  v_cndmask_b32 v14, v14, v0, vcc
  s_getreg_b32 s79, hwreg(HW_REG_XCC_ID)
  s_and_b32 s79, s79, 7
  s_and_b32 s101, s2, 0xf8
  s_or_b32 s101, s101, s79
  s_bfe_u32 s82, s101, 0x20001
  s_lshr_b32 s83, s101, 3
  s_lshl_b32 s93, s28, 1
  s_add_u32 s83, s83, s93
  s_and_b32 s93, s83, 3
  s_bitcmp1_b32 s101, 0
  s_cselect_b32 s88, s93, s82
  s_cselect_b32 s93, s82, s93
  s_lshl_b32 s88, s88, 2
  s_or_b32 s88, s88, s93
  s_lshl_b32 s88, s88, 1
  s_bfe_u32 s93, s83, 0x10002
  s_or_b32 s88, s88, s93
  s_mul_i32 s87, s88, 393216
  s_add_u32 s87, s87, 44040192
  s_mul_i32 s89, s88, 393216
  s_add_u32 s89, s89, 44040192
  s_mul_i32 s88, s88, 4352
  s_add_u32 s88, s88, 1048576
  s_and_b32 s79, s79, 1
  s_mov_b32 s78, s79
  s_mov_b32 s99, 1
  s_lshl_b32 s85, s3, 2
  s_or_b32 s85, s85, s28
  s_sub_u32 s93, 63, s85
  s_cmp_eq_u32 s79, 0
  s_cselect_b32 s86, 1, 0x10000
  s_cselect_b32 s85, s85, s93
  s_cselect_b32 s83, 16, -16
  s_mul_i32 s83, s83, 6144
  s_mul_i32 s85, s85, 6144
  s_add_u32 s85, s85, s87
  s_and_b32 s75, s3, 3
  v_mul_u32_u24 v146, 384, v144
  v_bfe_u32 v154, v144, 1, 3
  v_xor_b32 v154, v154, v145
  v_lshlrev_b32 v154, 4, v154
  v_add_u32 v7, v146, v154
  v_xor_b32 v154, 64, v154
  v_add_u32 v8, v146, v154
  v_mul_u32_u24 v147, 1536, v145
  v_lshl_add_u32 v11, v144, 4, v147
  v_lshl_add_u32 v12, v144, 3, v147
  v_add_u32 v12, 256, v12
  v_lshlrev_b32 v152, 4, v0
  v_add_u32 v13, 122880, v152
  s_mul_i32 s35, s28, 12288
  v_add_u32 v157, s35, v13
  s_waitcnt vmcnt(24)
  v_perm_b32 v40, v164, v160, s33
  v_perm_b32 v41, v172, v168, s33
  v_perm_b32 v42, v180, v176, s33
  v_perm_b32 v43, v188, v184, s33
  ds_write_b128 v157, v[40:43] offset:0
  v_perm_b32 v44, v164, v160, s34
  v_perm_b32 v45, v172, v168, s34
  v_perm_b32 v46, v180, v176, s34
  v_perm_b32 v47, v188, v184, s34
  ds_write_b128 v157, v[44:47] offset:1024
  v_perm_b32 v48, v165, v161, s33
  v_perm_b32 v49, v173, v169, s33
  v_perm_b32 v50, v181, v177, s33
  v_perm_b32 v51, v189, v185, s33
  ds_write_b128 v157, v[48:51] offset:2048
  v_perm_b32 v52, v165, v161, s34
  v_perm_b32 v53, v173, v169, s34
  v_perm_b32 v54, v181, v177, s34
  v_perm_b32 v55, v189, v185, s34
  ds_write_b128 v157, v[52:55] offset:3072
  v_perm_b32 v56, v166, v162, s33
  v_perm_b32 v57, v174, v170, s33
  v_perm_b32 v58, v182, v178, s33
  v_perm_b32 v59, v190, v186, s33
  ds_write_b128 v157, v[56:59] offset:4096
  v_perm_b32 v60, v166, v162, s34
  v_perm_b32 v61, v174, v170, s34
  v_perm_b32 v62, v182, v178, s34
  v_perm_b32 v63, v190, v186, s34
  ds_write_b128 v157, v[60:63] offset:5120
  v_perm_b32 v64, v167, v163, s33
  v_perm_b32 v65, v175, v171, s33
  v_perm_b32 v66, v183, v179, s33
  v_perm_b32 v67, v191, v187, s33
  ds_write_b128 v157, v[64:67] offset:6144
  v_perm_b32 v68, v167, v163, s34
  v_perm_b32 v69, v175, v171, s34
  v_perm_b32 v70, v183, v179, s34
  v_perm_b32 v71, v191, v187, s34
  ds_write_b128 v157, v[68:71] offset:7168
  v_perm_b32 v72, v194, v192, s33
  v_perm_b32 v73, v198, v196, s33
  v_perm_b32 v74, v202, v200, s33
  v_perm_b32 v75, v206, v204, s33
  ds_write_b128 v157, v[72:75] offset:8192
  v_perm_b32 v76, v194, v192, s34
  v_perm_b32 v77, v198, v196, s34
  v_perm_b32 v78, v202, v200, s34
  v_perm_b32 v79, v206, v204, s34
  ds_write_b128 v157, v[76:79] offset:9216
  v_perm_b32 v80, v195, v193, s33
  v_perm_b32 v81, v199, v197, s33
  v_perm_b32 v82, v203, v201, s33
  v_perm_b32 v83, v207, v205, s33
  ds_write_b128 v157, v[80:83] offset:10240
  v_perm_b32 v84, v195, v193, s34
  v_perm_b32 v85, v199, v197, s34
  v_perm_b32 v86, v203, v201, s34
  v_perm_b32 v87, v207, v205, s34
  ds_write_b128 v157, v[84:87] offset:11264
  s_waitcnt lgkmcnt(0)
  s_barrier
  ds_read_b128 a[0:3], v13 offset:0
  ds_read_b128 a[4:7], v13 offset:1024
  ds_read_b128 a[8:11], v13 offset:2048
  ds_read_b128 a[12:15], v13 offset:3072
  ds_read_b128 a[16:19], v13 offset:4096
  ds_read_b128 a[20:23], v13 offset:5120
  ds_read_b128 a[24:27], v13 offset:6144
  ds_read_b128 a[28:31], v13 offset:7168
  ds_read_b128 a[32:35], v13 offset:8192
  ds_read_b128 a[36:39], v13 offset:9216
  ds_read_b128 a[40:43], v13 offset:10240
  ds_read_b128 a[44:47], v13 offset:11264
  ds_read_b128 a[96:99], v13 offset:12288
  ds_read_b128 a[100:103], v13 offset:13312
  ds_read_b128 a[104:107], v13 offset:14336
  ds_read_b128 a[108:111], v13 offset:15360
  ds_read_b128 a[112:115], v13 offset:16384
  ds_read_b128 a[116:119], v13 offset:17408
  ds_read_b128 a[120:123], v13 offset:18432
  ds_read_b128 a[124:127], v13 offset:19456
  ds_read_b128 a[128:131], v13 offset:20480
  ds_read_b128 a[132:135], v13 offset:21504
  ds_read_b128 a[136:139], v13 offset:22528
  ds_read_b128 a[140:143], v13 offset:23552
  ds_read_b128 a[192:195], v13 offset:24576
  ds_read_b128 a[196:199], v13 offset:25600
  ds_read_b128 a[200:203], v13 offset:26624
  ds_read_b128 a[204:207], v13 offset:27648
  ds_read_b128 a[208:211], v13 offset:28672
  ds_read_b128 a[212:215], v13 offset:29696
  ds_read_b128 a[216:219], v13 offset:30720
  ds_read_b128 a[220:223], v13 offset:31744
  ds_read_b128 a[224:227], v13 offset:32768
  ds_read_b128 a[228:231], v13 offset:33792
  ds_read_b128 a[232:235], v13 offset:34816
  ds_read_b128 a[236:239], v13 offset:35840
  s_bitcmp1_b32 s74, 4
  s_cbranch_scc0 L_ps0
  s_mov_b32 m0, s38
  s_add_u32 s40, s38, 4096
  buffer_load_dwordx4 v1, s[12:15], s37 offen nt lds
  buffer_load_dwordx4 v2, s[12:15], s37 offen offset:1024 nt lds
  buffer_load_dwordx4 v3, s[12:15], s37 offen offset:2048 nt lds
  buffer_load_dwordx4 v4, s[12:15], s37 offen offset:3072 nt lds
  s_mov_b32 m0, s40
  s_nop 0
  buffer_load_dwordx4 v5, s[12:15], s37 offen nt lds
  buffer_load_dwordx4 v6, s[12:15], s37 offen offset:1024 nt lds
  s_add_u32 s37, s37, 6291456
  s_add_u32 s38, s38, 6144
L_ps0:
  s_waitcnt vmcnt(14)
  s_bitcmp1_b32 0x3, s75
  s_cbranch_scc1 L_wm1
  s_waitcnt vmcnt(8)
L_wm1:
  v_perm_b32 v40, v212, v208, s33
  v_perm_b32 v41, v220, v216, s33
  v_perm_b32 v42, v228, v224, s33
  v_perm_b32 v43, v236, v232, s33
  v_perm_b32 v44, v212, v208, s34
  v_perm_b32 v45, v220, v216, s34
  v_perm_b32 v46, v228, v224, s34
  v_perm_b32 v47, v236, v232, s34
  v_perm_b32 v48, v213, v209, s33
  v_perm_b32 v49, v221, v217, s33
  v_perm_b32 v50, v229, v225, s33
  v_perm_b32 v51, v237, v233, s33
  v_perm_b32 v52, v213, v209, s34
  v_perm_b32 v53, v221, v217, s34
  v_perm_b32 v54, v229, v225, s34
  v_perm_b32 v55, v237, v233, s34
  v_perm_b32 v56, v214, v210, s33
  v_perm_b32 v57, v222, v218, s33
  v_perm_b32 v58, v230, v226, s33
  v_perm_b32 v59, v238, v234, s33
  v_perm_b32 v60, v214, v210, s34
  v_perm_b32 v61, v222, v218, s34
  v_perm_b32 v62, v230, v226, s34
  v_perm_b32 v63, v238, v234, s34
  v_perm_b32 v64, v215, v211, s33
  v_perm_b32 v65, v223, v219, s33
  v_perm_b32 v66, v231, v227, s33
  v_perm_b32 v67, v239, v235, s33
  v_perm_b32 v68, v215, v211, s34
  v_perm_b32 v69, v223, v219, s34
  v_perm_b32 v70, v231, v227, s34
  v_perm_b32 v71, v239, v235, s34
  v_perm_b32 v72, v242, v240, s33
  v_perm_b32 v73, v246, v244, s33
  v_perm_b32 v74, v250, v248, s33
  v_perm_b32 v75, v254, v252, s33
  v_perm_b32 v76, v242, v240, s34
  v_perm_b32 v77, v246, v244, s34
  v_perm_b32 v78, v250, v248, s34
  v_perm_b32 v79, v254, v252, s34
  v_perm_b32 v80, v243, v241, s33
  v_perm_b32 v81, v247, v245, s33
  v_perm_b32 v82, v251, v249, s33
  v_perm_b32 v83, v255, v253, s33
  v_perm_b32 v84, v243, v241, s34
  v_perm_b32 v85, v247, v245, s34
  v_perm_b32 v86, v251, v249, s34
  v_perm_b32 v87, v255, v253, s34
  s_waitcnt lgkmcnt(0)
  s_barrier
  ds_write_b128 v157, v[40:43] offset:0
  ds_write_b128 v157, v[44:47] offset:1024
  ds_write_b128 v157, v[48:51] offset:2048
  ds_write_b128 v157, v[52:55] offset:3072
  ds_write_b128 v157, v[56:59] offset:4096
  ds_write_b128 v157, v[60:63] offset:5120
  ds_write_b128 v157, v[64:67] offset:6144
  ds_write_b128 v157, v[68:71] offset:7168
  ds_write_b128 v157, v[72:75] offset:8192
  ds_write_b128 v157, v[76:79] offset:9216
  ds_write_b128 v157, v[80:83] offset:10240
  ds_write_b128 v157, v[84:87] offset:11264
  s_bitcmp1_b32 s74, 5
  s_cbranch_scc0 L_ps2
  s_mov_b32 m0, s38
  s_add_u32 s40, s38, 4096
  buffer_load_dwordx4 v1, s[12:15], s37 offen nt lds
  buffer_load_dwordx4 v2, s[12:15], s37 offen offset:1024 nt lds
  buffer_load_dwordx4 v3, s[12:15], s37 offen offset:2048 nt lds
  buffer_load_dwordx4 v4, s[12:15], s37 offen offset:3072 nt lds
  s_mov_b32 m0, s40
  s_nop 0
  buffer_load_dwordx4 v5, s[12:15], s37 offen nt lds
  buffer_load_dwordx4 v6, s[12:15], s37 offen offset:1024 nt lds
  s_add_u32 s37, s37, 6291456
  s_add_u32 s38, s38, 6144
  s_mov_b32 m0, s38
  s_add_u32 s40, s38, 4096
  buffer_load_dwordx4 v1, s[12:15], s37 offen nt lds
  buffer_load_dwordx4 v2, s[12:15], s37 offen offset:1024 nt lds
  buffer_load_dwordx4 v3, s[12:15], s37 offen offset:2048 nt lds
  buffer_load_dwordx4 v4, s[12:15], s37 offen offset:3072 nt lds
  s_mov_b32 m0, s40
  s_nop 0
  buffer_load_dwordx4 v5, s[12:15], s37 offen nt lds
  buffer_load_dwordx4 v6, s[12:15], s37 offen offset:1024 nt lds
  s_add_u32 s37, s37, 6291456
  s_add_u32 s38, s38, 6144
L_ps2:
  s_waitcnt lgkmcnt(0)
  s_barrier
  s_branch L_join
L_w3:
  s_waitcnt lgkmcnt(0)
  s_mov_b32 s12, s4
  s_and_b32 s13, s5, 0xffff
  s_mov_b32 m0, s38
  s_add_u32 s40, s38, 4096
  buffer_load_dwordx4 v1, s[12:15], s37 offen nt lds
  buffer_load_dwordx4 v2, s[12:15], s37 offen offset:1024 nt lds
  buffer_load_dwordx4 v3, s[12:15], s37 offen offset:2048 nt lds
  buffer_load_dwordx4 v4, s[12:15], s37 offen offset:3072 nt lds
  s_mov_b32 m0, s40
  s_nop 0
  buffer_load_dwordx4 v5, s[12:15], s37 offen nt lds
  buffer_load_dwordx4 v6, s[12:15], s37 offen offset:1024 nt lds
  s_add_u32 s37, s37, 6291456
  s_add_u32 s38, s38, 6144
  s_mov_b32 s20, s8
  s_and_b32 s21, s9, 0xffff
  buffer_load_dwordx4 v[88:91], v150, s[20:23], 0 offen
  buffer_load_dwordx2 v[92:93], v151, s[20:23], 0 offen offset:256
  s_mov_b32 m0, s38
  s_add_u32 s40, s38, 4096
  buffer_load_dwordx4 v1, s[12:15], s37 offen nt lds
  buffer_load_dwordx4 v2, s[12:15], s37 offen offset:1024 nt lds
  buffer_load_dwordx4 v3, s[12:15], s37 offen offset:2048 nt lds
  buffer_load_dwordx4 v4, s[12:15], s37 offen offset:3072 nt lds
  s_mov_b32 m0, s40
  s_nop 0
  buffer_load_dwordx4 v5, s[12:15], s37 offen nt lds
  buffer_load_dwordx4 v6, s[12:15], s37 offen offset:1024 nt lds
  s_add_u32 s37, s37, 6291456
  s_add_u32 s38, s38, 6144
  s_mov_b32 m0, s38
  s_add_u32 s40, s38, 4096
  buffer_load_dwordx4 v1, s[12:15], s37 offen nt lds
  buffer_load_dwordx4 v2, s[12:15], s37 offen offset:1024 nt lds
  buffer_load_dwordx4 v3, s[12:15], s37 offen offset:2048 nt lds
  buffer_load_dwordx4 v4, s[12:15], s37 offen offset:3072 nt lds
  s_mov_b32 m0, s40
  s_nop 0
  buffer_load_dwordx4 v5, s[12:15], s37 offen nt lds
  buffer_load_dwordx4 v6, s[12:15], s37 offen offset:1024 nt lds
  s_add_u32 s37, s37, 6291456
  s_add_u32 s38, s38, 6144
  s_bitcmp1_b32 s74, 3
  s_cbranch_scc0 L_ps3
  s_mov_b32 m0, s38
  s_add_u32 s40, s38, 4096
  buffer_load_dwordx4 v1, s[12:15], s37 offen nt lds
  buffer_load_dwordx4 v2, s[12:15], s37 offen offset:1024 nt lds
  buffer_load_dwordx4 v3, s[12:15], s37 offen offset:2048 nt lds
  buffer_load_dwordx4 v4, s[12:15], s37 offen offset:3072 nt lds
  s_mov_b32 m0, s40
  s_nop 0
  buffer_load_dwordx4 v5, s[12:15], s37 offen nt lds
  buffer_load_dwordx4 v6, s[12:15], s37 offen offset:1024 nt lds
  s_add_u32 s37, s37, 6291456
  s_add_u32 s38, s38, 6144
L_ps3:
  s_cmp_ge_u32 s2, 8
  s_cbranch_scc1 L_tlw
  s_load_dword s72, s[46:47], 0xffffc
L_tlw:
  s_mul_i32 s31, s30, 6144
  s_mul_i32 s32, s28, 30720
  s_add_u32 s43, s32, 30720
  s_mov_b32 s24, s10
  s_and_b32 s25, s11, 0xffff
  s_mov_b32 s26, 56623104
  s_mov_b32 s27, 0x00020000
  s_mov_b32 s48, s46
  s_and_b32 s49, s47, 0xffff
  s_mov_b32 s50, 2097152
  s_mov_b32 s51, 0x00020000
  s_mov_b32 s94, 268435456
  v_mov_b32 v14, s94
  v_cmp_eq_u32 vcc, 0, v0
  v_cndmask_b32 v14, v14, v0, vcc
  s_getreg_b32 s79, hwreg(HW_REG_XCC_ID)
  s_and_b32 s79, s79, 7
  s_and_b32 s101, s2, 0xf8
  s_or_b32 s101, s101, s79
  s_bfe_u32 s82, s101, 0x20001
  s_lshr_b32 s83, s101, 3
  s_lshl_b32 s93, s28, 1
  s_add_u32 s83, s83, s93
  s_and_b32 s93, s83, 3
  s_bitcmp1_b32 s101, 0
  s_cselect_b32 s88, s93, s82
  s_cselect_b32 s93, s82, s93
  s_lshl_b32 s88, s88, 2
  s_or_b32 s88, s88, s93
  s_lshl_b32 s88, s88, 1
  s_bfe_u32 s93, s83, 0x10002
  s_or_b32 s88, s88, s93
  s_mul_i32 s87, s88, 393216
  s_add_u32 s87, s87, 44040192
  s_bfe_u32 s82, s2, 0x20001
  s_lshr_b32 s83, s2, 3
  s_lshl_b32 s93, s28, 1
  s_add_u32 s83, s83, s93
  s_and_b32 s93, s83, 3
  s_bitcmp1_b32 s2, 0
  s_cselect_b32 s100, s93, s82
  s_cselect_b32 s93, s82, s93
  s_lshl_b32 s100, s100, 2
  s_or_b32 s100, s100, s93
  s_lshl_b32 s100, s100, 1
  s_bfe_u32 s93, s83, 0x10002
  s_or_b32 s100, s100, s93
  s_and_b32 s93, s2, 0xc1
  s_cmp_eq_u32 s93, 0
  s_cselect_b32 s88, s100, s88
  s_mul_i32 s89, s88, 393216
  s_add_u32 s89, s89, 44040192
  s_mul_i32 s88, s88, 4352
  s_add_u32 s88, s88, 1048576
  s_cmp_eq_u32 s93, 0
  s_cselect_b32 s98, s88, s94
  s_and_b32 s79, s79, 1
  s_mov_b32 s78, s79
  s_mov_b32 s99, 1
  s_lshl_b32 s85, s3, 2
  s_or_b32 s85, s85, s28
  s_sub_u32 s93, 63, s85
  s_cmp_eq_u32 s79, 0
  s_cselect_b32 s86, 1, 0x10000
  s_cselect_b32 s85, s85, s93
  s_cselect_b32 s83, 16, -16
  s_mul_i32 s83, s83, 6144
  s_mul_i32 s85, s85, 6144
  s_add_u32 s85, s85, s87
  s_and_b32 s75, s3, 3
  s_add_u32 s75, s75, 4
  v_mul_u32_u24 v146, 384, v144
  v_bfe_u32 v154, v144, 1, 3
  v_xor_b32 v154, v154, v145
  v_lshlrev_b32 v154, 4, v154
  v_add_u32 v7, v146, v154
  v_xor_b32 v154, 64, v154
  v_add_u32 v8, v146, v154
  v_mul_u32_u24 v147, 1536, v145
  v_lshl_add_u32 v11, v144, 4, v147
  v_lshl_add_u32 v12, v144, 3, v147
  v_add_u32 v12, 256, v12
  v_lshlrev_b32 v152, 4, v0
  v_add_u32 v13, 122880, v152
  s_mul_i32 s35, s28, 12288
  v_add_u32 v157, s35, v13
  s_barrier
  ds_read_b128 a[0:3], v13 offset:0
  ds_read_b128 a[4:7], v13 offset:1024
  ds_read_b128 a[8:11], v13 offset:2048
  ds_read_b128 a[12:15], v13 offset:3072
  ds_read_b128 a[16:19], v13 offset:4096
  ds_read_b128 a[20:23], v13 offset:5120
  ds_read_b128 a[24:27], v13 offset:6144
  ds_read_b128 a[28:31], v13 offset:7168
  ds_read_b128 a[32:35], v13 offset:8192
  ds_read_b128 a[36:39], v13 offset:9216
  ds_read_b128 a[40:43], v13 offset:10240
  ds_read_b128 a[44:47], v13 offset:11264
  ds_read_b128 a[96:99], v13 offset:12288
  ds_read_b128 a[100:103], v13 offset:13312
  ds_read_b128 a[104:107], v13 offset:14336
  ds_read_b128 a[108:111], v13 offset:15360
  ds_read_b128 a[112:115], v13 offset:16384
  ds_read_b128 a[116:119], v13 offset:17408
  ds_read_b128 a[120:123], v13 offset:18432
  ds_read_b128 a[124:127], v13 offset:19456
  ds_read_b128 a[128:131], v13 offset:20480
  ds_read_b128 a[132:135], v13 offset:21504
  ds_read_b128 a[136:139], v13 offset:22528
  ds_read_b128 a[140:143], v13 offset:23552
  ds_read_b128 a[192:195], v13 offset:24576
  ds_read_b128 a[196:199], v13 offset:25600
  ds_read_b128 a[200:203], v13 offset:26624
  ds_read_b128 a[204:207], v13 offset:27648
  ds_read_b128 a[208:211], v13 offset:28672
  ds_read_b128 a[212:215], v13 offset:29696
  ds_read_b128 a[216:219], v13 offset:30720
  ds_read_b128 a[220:223], v13 offset:31744
  ds_read_b128 a[224:227], v13 offset:32768
  ds_read_b128 a[228:231], v13 offset:33792
  ds_read_b128 a[232:235], v13 offset:34816
  ds_read_b128 a[236:239], v13 offset:35840
  s_bitcmp1_b32 s74, 4
  s_cbranch_scc0 L_ps4
  s_mov_b32 m0, s38
  s_add_u32 s40, s38, 4096
  buffer_load_dwordx4 v1, s[12:15], s37 offen nt lds
  buffer_load_dwordx4 v2, s[12:15], s37 offen offset:1024 nt lds
  buffer_load_dwordx4 v3, s[12:15], s37 offen offset:2048 nt lds
  buffer_load_dwordx4 v4, s[12:15], s37 offen offset:3072 nt lds
  s_mov_b32 m0, s40
  s_nop 0
  buffer_load_dwordx4 v5, s[12:15], s37 offen nt lds
  buffer_load_dwordx4 v6, s[12:15], s37 offen offset:1024 nt lds
  s_add_u32 s37, s37, 6291456
  s_add_u32 s38, s38, 6144
L_ps4:
  s_waitcnt lgkmcnt(0)
  s_barrier
  s_barrier
  v_mov_b32 v15, 0
  buffer_atomic_swap v15, v14, s[48:51], s98 offen sc0 sc1
L_join:
  ds_read_b128 a[48:51], v13 offset:0
  ds_read_b128 a[52:55], v13 offset:1024
  ds_read_b128 a[56:59], v13 offset:2048
  ds_read_b128 a[60:63], v13 offset:3072
  ds_read_b128 a[64:67], v13 offset:4096
  ds_read_b128 a[68:71], v13 offset:5120
  ds_read_b128 a[72:75], v13 offset:6144
  ds_read_b128 a[76:79], v13 offset:7168
  ds_read_b128 a[80:83], v13 offset:8192
  ds_read_b128 a[84:87], v13 offset:9216
  ds_read_b128 a[88:91], v13 offset:10240
  ds_read_b128 a[92:95], v13 offset:11264
  ds_read_b128 a[144:147], v13 offset:12288
  ds_read_b128 a[148:151], v13 offset:13312
  ds_read_b128 a[152:155], v13 offset:14336
  ds_read_b128 a[156:159], v13 offset:15360
  ds_read_b128 a[160:163], v13 offset:16384
  ds_read_b128 a[164:167], v13 offset:17408
  ds_read_b128 a[168:171], v13 offset:18432
  ds_read_b128 a[172:175], v13 offset:19456
  ds_read_b128 a[176:179], v13 offset:20480
  ds_read_b128 a[180:183], v13 offset:21504
  ds_read_b128 a[184:187], v13 offset:22528
  ds_read_b128 a[188:191], v13 offset:23552
  ds_read_b128 a[240:243], v13 offset:24576
  ds_read_b128 a[244:247], v13 offset:25600
  ds_read_b128 a[248:251], v13 offset:26624
  ds_read_b128 a[252:255], v13 offset:27648
  ds_read_b128 v[112:115], v13 offset:28672
  ds_read_b128 v[116:119], v13 offset:29696
  ds_read_b128 v[120:123], v13 offset:30720
  ds_read_b128 v[124:127], v13 offset:31744
  ds_read_b128 v[128:131], v13 offset:32768
  ds_read_b128 v[132:135], v13 offset:33792
  ds_read_b128 v[136:139], v13 offset:34816
  ds_read_b128 v[140:143], v13 offset:35840
  s_waitcnt vmcnt(24)
  s_bitcmp1_b32 0x3, s75
  s_cbranch_scc1 L_wm5
  s_waitcnt vmcnt(19)
  s_bitcmp1_b32 0xf0, s75
  s_cbranch_scc1 L_wm5
  s_waitcnt vmcnt(6)
L_wm5:
  v_lshlrev_b32 v144, 16, v88
  v_lshlrev_b32 v145, 16, v88
  v_lshlrev_b32 v146, 16, v88
  v_lshlrev_b32 v147, 16, v88
  v_and_b32 v148, 0xffff0000, v88
  v_and_b32 v149, 0xffff0000, v88
  v_and_b32 v150, 0xffff0000, v88
  v_and_b32 v151, 0xffff0000, v88
  v_lshlrev_b32 v152, 16, v89
  v_lshlrev_b32 v153, 16, v89
  v_lshlrev_b32 v154, 16, v89
  v_lshlrev_b32 v155, 16, v89
  v_and_b32 v156, 0xffff0000, v89
  v_and_b32 v157, 0xffff0000, v89
  v_and_b32 v158, 0xffff0000, v89
  v_and_b32 v159, 0xffff0000, v89
  v_lshlrev_b32 v160, 16, v90
  v_lshlrev_b32 v161, 16, v90
  v_lshlrev_b32 v162, 16, v90
  v_lshlrev_b32 v163, 16, v90
  v_and_b32 v164, 0xffff0000, v90
  v_and_b32 v165, 0xffff0000, v90
  v_and_b32 v166, 0xffff0000, v90
  v_and_b32 v167, 0xffff0000, v90
  v_lshlrev_b32 v168, 16, v91
  v_lshlrev_b32 v169, 16, v91
  v_lshlrev_b32 v170, 16, v91
  v_lshlrev_b32 v171, 16, v91
  v_and_b32 v172, 0xffff0000, v91
  v_and_b32 v173, 0xffff0000, v91
  v_and_b32 v174, 0xffff0000, v91
  v_and_b32 v175, 0xffff0000, v91
  v_lshlrev_b32 v176, 16, v92
  v_lshlrev_b32 v177, 16, v92
  v_lshlrev_b32 v178, 16, v92
  v_lshlrev_b32 v179, 16, v92
  v_and_b32 v180, 0xffff0000, v92
  v_and_b32 v181, 0xffff0000, v92
  v_and_b32 v182, 0xffff0000, v92
  v_and_b32 v183, 0xffff0000, v92
  v_lshlrev_b32 v184, 16, v93
  v_lshlrev_b32 v185, 16, v93
  v_lshlrev_b32 v186, 16, v93
  v_lshlrev_b32 v187, 16, v93
  v_and_b32 v188, 0xffff0000, v93
  v_and_b32 v189, 0xffff0000, v93
  v_and_b32 v190, 0xffff0000, v93
  v_and_b32 v191, 0xffff0000, v93
  s_mov_b32 m0, s38
  s_add_u32 s40, s38, 4096
  buffer_load_dwordx4 v1, s[12:15], s37 offen nt lds
  buffer_load_dwordx4 v2, s[12:15], s37 offen offset:1024 nt lds
  buffer_load_dwordx4 v3, s[12:15], s37 offen offset:2048 nt lds
  buffer_load_dwordx4 v4, s[12:15], s37 offen offset:3072 nt lds
  s_mov_b32 m0, s40
  s_nop 0
  buffer_load_dwordx4 v5, s[12:15], s37 offen nt lds
  buffer_load_dwordx4 v6, s[12:15], s37 offen offset:1024 nt lds
  s_add_u32 s37, s37, 6291456
  s_add_u32 s38, s38, 6144
  s_mov_b32 s38, s32
  v_lshlrev_b32 v204, 7, v0
  v_cmp_gt_u32 vcc, 48, v0
  v_mov_b32 v205, s94
  v_cndmask_b32 v204, v205, v204, vcc
  s_waitcnt vmcnt(24)
  v_add_u32 v9, s32, v7
  v_add_u32 v10, s32, v8
  ds_read_b128 v[16:19], v9 offset:0
  ds_read_b128 v[20:23], v10 offset:0
  ds_read_b128 v[24:27], v9 offset:128
  ds_read_b128 v[28:31], v10 offset:128
  ds_read_b128 v[32:35], v9 offset:256
  ds_read_b128 v[36:39], v10 offset:256
  s_mov_b32 s39, 0
  s_add_u32 s41, s32, 6144
  s_mov_b32 s42, s31
  s_mov_b32 s47, 268435456
  s_lshl_b32 s95, s78, 2
  s_add_u32 s95, s95, s3
  s_mov_b32 s93, 0x4330314
  s_cmp_eq_u32 s95, 2
  s_cselect_b32 s93, 0x32b030c, s93
  s_cmp_eq_u32 s95, 3
  s_cselect_b32 s93, 0x32b030c, s93
  s_cmp_eq_u32 s95, 4
  s_cselect_b32 s93, 0x2270306, s93
  s_cmp_eq_u32 s95, 5
  s_cselect_b32 s93, 0x2270306, s93
  s_cmp_eq_u32 s95, 6
  s_cselect_b32 s93, 0x2270306, s93
  s_cmp_eq_u32 s95, 7
  s_cselect_b32 s93, 0x2270306, s93
  s_and_b32 s91, s93, 63
  s_bfe_u32 s84, s93, 0x60008
  s_bfe_u32 s92, s93, 0x60010
  s_lshr_b32 s73, s93, 24
  s_xor_b32 s90, s91, 63
  s_waitcnt lgkmcnt(6)
  s_bitcmp1_b32 s90, s39
  s_cbranch_scc1 L_N
  s_branch L_D
L_auxN:
  s_cmp_lg_u32 s39, s73
  s_cbranch_scc1 L_nbarN
  s_barrier
L_nbarN:
  s_bitcmp1_b32 s84, s39
  s_cbranch_scc0 L_ntN
  buffer_load_dword v205, v204, s[12:15], s85 offen
  s_add_u32 s85, s85, s83
L_ntN:
  s_cmp_lg_u32 s39, 5
  s_cbranch_scc1 L_retN
  s_waitcnt vmcnt(60)
  v_mov_b32 v15, s86
  buffer_atomic_add v15, v14, s[48:51], s88 offen sc0 sc1
  s_branch L_retN
L_auxD:
  s_cmp_lg_u32 s39, s73
  s_cbranch_scc1 L_nbarD
  s_barrier
L_nbarD:
  s_bitcmp1_b32 s84, s39
  s_cbranch_scc0 L_ntD
  buffer_load_dword v205, v204, s[12:15], s85 offen
  s_add_u32 s85, s85, s83
L_ntD:
  s_cmp_lg_u32 s39, 5
  s_cbranch_scc1 L_retD
  s_waitcnt vmcnt(60)
  v_mov_b32 v15, s86
  buffer_atomic_add v15, v14, s[48:51], s88 offen sc0 sc1
  s_branch L_retD
L_fail:
  s_mov_b32 s99, 0
  s_mov_b32 s90, 0
  s_mov_b32 s91, 0
  s_mov_b32 s92, 0
  s_branch L_retN
.p2align 3
L_N:
  s_waitcnt lgkmcnt(3)
  s_nop 0
  v_mfma_f32_16x16x32_bf16 v[40:43], v[16:19], a[0:3], v[144:147]
  v_mfma_f32_16x16x32_bf16 v[44:47], v[16:19], a[4:7], v[148:151]
  v_mfma_f32_16x16x32_bf16 v[40:43], v[20:23], a[48:51], v[40:43]
  v_mfma_f32_16x16x32_bf16 v[44:47], v[20:23], a[52:55], v[44:47]
  v_mfma_f32_16x16x32_bf16 v[40:43], v[24:27], a[96:99], v[40:43]
  v_cvt_pk_bf16_f32 v93, v80, v84
  v_cvt_pk_bf16_f32 v99, v81, v85
  v_mfma_f32_16x16x32_bf16 v[44:47], v[24:27], a[100:103], v[44:47]
  v_cvt_pk_bf16_f32 v105, v82, v86
  s_waitcnt lgkmcnt(0)
  s_nop 0
  v_mfma_f32_16x16x32_bf16 v[40:43], v[28:31], a[144:147], v[40:43]
  v_cvt_pk_bf16_f32 v111, v83, v87
  v_mfma_f32_16x16x32_bf16 v[44:47], v[28:31], a[148:151], v[44:47]
  v_mfma_f32_16x16x32_bf16 v[40:43], v[32:35], a[192:195], v[40:43]
  v_mfma_f32_16x16x32_bf16 v[44:47], v[32:35], a[196:199], v[44:47]
  v_mfma_f32_16x16x32_bf16 v[40:43], v[36:39], a[240:243], v[40:43]
  v_mfma_f32_16x16x32_bf16 v[44:47], v[36:39], a[244:247], v[44:47]
  s_bitcmp1_b32 s92, s39
  s_cbranch_scc1 L_auxN
L_retN:
  v_mfma_f32_16x16x32_bf16 v[48:51], v[16:19], a[8:11], v[152:155]
  v_mfma_f32_16x16x32_bf16 v[52:55], v[16:19], a[12:15], v[156:159]
  v_mfma_f32_16x16x32_bf16 v[48:51], v[20:23], a[56:59], v[48:51]
  v_mfma_f32_16x16x32_bf16 v[52:55], v[20:23], a[60:63], v[52:55]
  v_mfma_f32_16x16x32_bf16 v[48:51], v[24:27], a[104:107], v[48:51]
  v_mfma_f32_16x16x32_bf16 v[52:55], v[24:27], a[108:111], v[52:55]
  v_cvt_pk_bf16_f32 v88, v40, v44
  v_cvt_pk_bf16_f32 v94, v41, v45
  v_mfma_f32_16x16x32_bf16 v[48:51], v[28:31], a[152:155], v[48:51]
  v_cvt_pk_bf16_f32 v100, v42, v46
  v_cvt_pk_bf16_f32 v106, v43, v47
  v_mfma_f32_16x16x32_bf16 v[52:55], v[28:31], a[156:159], v[52:55]
  v_mfma_f32_16x16x32_bf16 v[48:51], v[32:35], a[200:203], v[48:51]
  v_mfma_f32_16x16x32_bf16 v[52:55], v[32:35], a[204:207], v[52:55]
  v_mfma_f32_16x16x32_bf16 v[48:51], v[36:39], a[248:251], v[48:51]
  v_mfma_f32_16x16x32_bf16 v[52:55], v[36:39], a[252:255], v[52:55]
  v_mfma_f32_16x16x32_bf16 v[56:59], v[16:19], a[16:19], v[160:163]
  v_mfma_f32_16x16x32_bf16 v[60:63], v[16:19], a[20:23], v[164:167]
  v_mfma_f32_16x16x32_bf16 v[56:59], v[20:23], a[64:67], v[56:59]
  v_mfma_f32_16x16x32_bf16 v[60:63], v[20:23], a[68:71], v[60:63]
  v_mfma_f32_16x16x32_bf16 v[56:59], v[24:27], a[112:115], v[56:59]
  v_mfma_f32_16x16x32_bf16 v[60:63], v[24:27], a[116:119], v[60:63]
  v_mfma_f32_16x16x32_bf16 v[56:59], v[28:31], a[160:163], v[56:59]
  buffer_store_dwordx2 v[92:93], v12, s[24:27], s47 offen sc0 sc1
  v_mfma_f32_16x16x32_bf16 v[60:63], v[28:31], a[164:167], v[60:63]
  v_cvt_pk_bf16_f32 v89, v48, v52
  v_cvt_pk_bf16_f32 v95, v49, v53
  v_mfma_f32_16x16x32_bf16 v[56:59], v[32:35], a[208:211], v[56:59]
  v_cvt_pk_bf16_f32 v101, v50, v54
  v_cvt_pk_bf16_f32 v107, v51, v55
  v_mfma_f32_16x16x32_bf16 v[60:63], v[32:35], a[212:215], v[60:63]
  v_mfma_f32_16x16x32_bf16 v[56:59], v[36:39], v[112:115], v[56:59]
  v_mfma_f32_16x16x32_bf16 v[60:63], v[36:39], v[116:119], v[60:63]
  v_mfma_f32_16x16x32_bf16 v[64:67], v[16:19], a[24:27], v[168:171]
  buffer_store_dwordx2 v[98:99], v12, s[24:27], s47 offen offset:384 sc0 sc1
  v_mfma_f32_16x16x32_bf16 v[68:71], v[16:19], a[28:31], v[172:175]
  v_add_u32 v9, s41, v7
  v_add_u32 v10, s41, v8
  v_mfma_f32_16x16x32_bf16 v[64:67], v[20:23], a[72:75], v[64:67]
  s_add_u32 s41, s41, 6144
  v_mfma_f32_16x16x32_bf16 v[68:71], v[20:23], a[76:79], v[68:71]
  s_cmp_eq_u32 s41, s43
  s_cselect_b32 s41, s32, s41
  v_mfma_f32_16x16x32_bf16 v[64:67], v[24:27], a[120:123], v[64:67]
  v_cvt_pk_bf16_f32 v90, v56, v60
  v_cvt_pk_bf16_f32 v96, v57, v61
  v_mfma_f32_16x16x32_bf16 v[68:71], v[24:27], a[124:127], v[68:71]
  v_cvt_pk_bf16_f32 v102, v58, v62
  v_cvt_pk_bf16_f32 v108, v59, v63
  v_mfma_f32_16x16x32_bf16 v[64:67], v[28:31], a[168:171], v[64:67]
  buffer_store_dwordx2 v[104:105], v12, s[24:27], s47 offen offset:768 sc0 sc1
  v_mfma_f32_16x16x32_bf16 v[68:71], v[28:31], a[172:175], v[68:71]
  v_mfma_f32_16x16x32_bf16 v[64:67], v[32:35], a[216:219], v[64:67]
  v_mfma_f32_16x16x32_bf16 v[68:71], v[32:35], a[220:223], v[68:71]
  v_mfma_f32_16x16x32_bf16 v[64:67], v[36:39], v[120:123], v[64:67]
  v_mfma_f32_16x16x32_bf16 v[68:71], v[36:39], v[124:127], v[68:71]
  v_mfma_f32_16x16x32_bf16 v[72:75], v[16:19], a[32:35], v[176:179]
  buffer_store_dwordx2 v[110:111], v12, s[24:27], s47 offen offset:1152 sc0 sc1
  v_mfma_f32_16x16x32_bf16 v[76:79], v[16:19], a[36:39], v[180:183]
  s_mov_b32 s47, s42
  s_add_u32 s39, s39, 1
  v_mfma_f32_16x16x32_bf16 v[72:75], v[20:23], a[80:83], v[72:75]
  s_add_u32 s42, s42, 6291456
  v_mfma_f32_16x16x32_bf16 v[76:79], v[20:23], a[84:87], v[76:79]
  v_cvt_pk_bf16_f32 v91, v64, v68
  v_cvt_pk_bf16_f32 v97, v65, v69
  v_mfma_f32_16x16x32_bf16 v[72:75], v[24:27], a[128:131], v[72:75]
  v_cvt_pk_bf16_f32 v103, v66, v70
  v_cvt_pk_bf16_f32 v109, v67, v71
  v_mfma_f32_16x16x32_bf16 v[76:79], v[24:27], a[132:135], v[76:79]
  v_mfma_f32_16x16x32_bf16 v[72:75], v[28:31], a[176:179], v[72:75]
  v_mfma_f32_16x16x32_bf16 v[76:79], v[28:31], a[180:183], v[76:79]
  v_mfma_f32_16x16x32_bf16 v[72:75], v[32:35], a[224:227], v[72:75]
  v_mfma_f32_16x16x32_bf16 v[76:79], v[32:35], a[228:231], v[76:79]
  v_mfma_f32_16x16x32_bf16 v[72:75], v[36:39], v[128:131], v[72:75]
  v_mfma_f32_16x16x32_bf16 v[76:79], v[36:39], v[132:135], v[76:79]
  s_waitcnt vmcnt(13)
  s_nop 0
  v_mfma_f32_16x16x32_bf16 v[80:83], v[16:19], a[40:43], v[184:187]
  v_mfma_f32_16x16x32_bf16 v[84:87], v[16:19], a[44:47], v[188:191]
  ds_read_b128 v[16:19], v9 offset:0
  v_mfma_f32_16x16x32_bf16 v[80:83], v[20:23], a[88:91], v[80:83]
  buffer_store_dwordx4 v[88:91], v11, s[24:27], s47 offen sc0 sc1
  v_mfma_f32_16x16x32_bf16 v[84:87], v[20:23], a[92:95], v[84:87]
  v_cvt_pk_bf16_f32 v92, v72, v76
  ds_read_b128 v[20:23], v10 offset:0
  v_mfma_f32_16x16x32_bf16 v[80:83], v[24:27], a[136:139], v[80:83]
  v_cvt_pk_bf16_f32 v98, v73, v77
  buffer_store_dwordx4 v[94:97], v11, s[24:27], s47 offen offset:384 sc0 sc1
  v_mfma_f32_16x16x32_bf16 v[84:87], v[24:27], a[140:143], v[84:87]
  v_cvt_pk_bf16_f32 v104, v74, v78
  ds_read_b128 v[24:27], v9 offset:128
  v_mfma_f32_16x16x32_bf16 v[80:83], v[28:31], a[184:187], v[80:83]
  v_cvt_pk_bf16_f32 v110, v75, v79
  v_mfma_f32_16x16x32_bf16 v[84:87], v[28:31], a[188:191], v[84:87]
  buffer_store_dwordx4 v[100:103], v11, s[24:27], s47 offen offset:768 sc0 sc1
  ds_read_b128 v[28:31], v10 offset:128
  v_mfma_f32_16x16x32_bf16 v[80:83], v[32:35], a[232:235], v[80:83]
  v_mfma_f32_16x16x32_bf16 v[84:87], v[32:35], a[236:239], v[84:87]
  ds_read_b128 v[32:35], v9 offset:256
  v_mfma_f32_16x16x32_bf16 v[80:83], v[36:39], v[136:139], v[80:83]
  buffer_store_dwordx4 v[106:109], v11, s[24:27], s47 offen offset:1152 sc0 sc1
  s_bitcmp1_b32 s90, s39
  s_nop 0
  v_mfma_f32_16x16x32_bf16 v[84:87], v[36:39], v[140:143], v[84:87]
  ds_read_b128 v[36:39], v10 offset:256
  s_cbranch_scc1 L_N
  s_bitcmp1_b32 s91, s39
  s_cbranch_scc0 L_nd
.p2align 3
L_D:
  s_waitcnt lgkmcnt(3)
  s_nop 0
  v_mfma_f32_16x16x32_bf16 v[40:43], v[16:19], a[0:3], v[144:147]
  v_mfma_f32_16x16x32_bf16 v[44:47], v[16:19], a[4:7], v[148:151]
  v_mfma_f32_16x16x32_bf16 v[40:43], v[20:23], a[48:51], v[40:43]
  v_mfma_f32_16x16x32_bf16 v[44:47], v[20:23], a[52:55], v[44:47]
  v_mfma_f32_16x16x32_bf16 v[40:43], v[24:27], a[96:99], v[40:43]
  v_cvt_pk_bf16_f32 v93, v80, v84
  v_cvt_pk_bf16_f32 v99, v81, v85
  v_mfma_f32_16x16x32_bf16 v[44:47], v[24:27], a[100:103], v[44:47]
  s_waitcnt lgkmcnt(0)
  s_mov_b32 m0, s38
  v_mfma_f32_16x16x32_bf16 v[40:43], v[28:31], a[144:147], v[40:43]
  v_cvt_pk_bf16_f32 v105, v82, v86
  v_cvt_pk_bf16_f32 v111, v83, v87
  v_mfma_f32_16x16x32_bf16 v[44:47], v[28:31], a[148:151], v[44:47]
  v_mfma_f32_16x16x32_bf16 v[40:43], v[32:35], a[192:195], v[40:43]
  v_mfma_f32_16x16x32_bf16 v[44:47], v[32:35], a[196:199], v[44:47]
  s_add_u32 s40, s38, 4096
  v_mfma_f32_16x16x32_bf16 v[40:43], v[36:39], a[240:243], v[40:43]
  v_mfma_f32_16x16x32_bf16 v[44:47], v[36:39], a[244:247], v[44:47]
  s_bitcmp1_b32 s92, s39
  s_cbranch_scc1 L_auxD
L_retD:
  v_mfma_f32_16x16x32_bf16 v[48:51], v[16:19], a[8:11], v[152:155]
  v_mfma_f32_16x16x32_bf16 v[52:55], v[16:19], a[12:15], v[156:159]
  buffer_load_dwordx4 v1, s[12:15], s37 offen nt lds
  v_mfma_f32_16x16x32_bf16 v[48:51], v[20:23], a[56:59], v[48:51]
  buffer_load_dwordx4 v2, s[12:15], s37 offen offset:1024 nt lds
  v_mfma_f32_16x16x32_bf16 v[52:55], v[20:23], a[60:63], v[52:55]
  v_cvt_pk_bf16_f32 v88, v40, v44
  buffer_load_dwordx4 v3, s[12:15], s37 offen offset:2048 nt lds
  v_mfma_f32_16x16x32_bf16 v[48:51], v[24:27], a[104:107], v[48:51]
  buffer_load_dwordx4 v4, s[12:15], s37 offen offset:3072 nt lds
  s_mov_b32 m0, s40
  s_nop 0
  v_mfma_f32_16x16x32_bf16 v[52:55], v[24:27], a[108:111], v[52:55]
  v_cvt_pk_bf16_f32 v94, v41, v45
  buffer_load_dwordx4 v5, s[12:15], s37 offen nt lds
  v_mfma_f32_16x16x32_bf16 v[48:51], v[28:31], a[152:155], v[48:51]
  v_cvt_pk_bf16_f32 v100, v42, v46
  buffer_load_dwordx4 v6, s[12:15], s37 offen offset:1024 nt lds
  v_mfma_f32_16x16x32_bf16 v[52:55], v[28:31], a[156:159], v[52:55]
  v_cvt_pk_bf16_f32 v106, v43, v47
  v_mfma_f32_16x16x32_bf16 v[48:51], v[32:35], a[200:203], v[48:51]
  s_add_u32 s38, s38, 6144
  v_mfma_f32_16x16x32_bf16 v[52:55], v[32:35], a[204:207], v[52:55]
  s_cmp_eq_u32 s38, s43
  s_cselect_b32 s38, s32, s38
  v_mfma_f32_16x16x32_bf16 v[48:51], v[36:39], a[248:251], v[48:51]
  s_add_u32 s37, s37, 6291456
  v_mfma_f32_16x16x32_bf16 v[52:55], v[36:39], a[252:255], v[52:55]
  v_mfma_f32_16x16x32_bf16 v[56:59], v[16:19], a[16:19], v[160:163]
  v_mfma_f32_16x16x32_bf16 v[60:63], v[16:19], a[20:23], v[164:167]
  v_mfma_f32_16x16x32_bf16 v[56:59], v[20:23], a[64:67], v[56:59]
  v_mfma_f32_16x16x32_bf16 v[60:63], v[20:23], a[68:71], v[60:63]
  v_mfma_f32_16x16x32_bf16 v[56:59], v[24:27], a[112:115], v[56:59]
  v_mfma_f32_16x16x32_bf16 v[60:63], v[24:27], a[116:119], v[60:63]
  v_mfma_f32_16x16x32_bf16 v[56:59], v[28:31], a[160:163], v[56:59]
  buffer_store_dwordx2 v[92:93], v12, s[24:27], s47 offen sc0 sc1
  v_mfma_f32_16x16x32_bf16 v[60:63], v[28:31], a[164:167], v[60:63]
  v_cvt_pk_bf16_f32 v89, v48, v52
  v_cvt_pk_bf16_f32 v95, v49, v53
  v_mfma_f32_16x16x32_bf16 v[56:59], v[32:35], a[208:211], v[56:59]
  v_cvt_pk_bf16_f32 v101, v50, v54
  v_cvt_pk_bf16_f32 v107, v51, v55
  v_mfma_f32_16x16x32_bf16 v[60:63], v[32:35], a[212:215], v[60:63]
  v_mfma_f32_16x16x32_bf16 v[56:59], v[36:39], v[112:115], v[56:59]
  v_mfma_f32_16x16x32_bf16 v[60:63], v[36:39], v[116:119], v[60:63]
  v_mfma_f32_16x16x32_bf16 v[64:67], v[16:19], a[24:27], v[168:171]
  buffer_store_dwordx2 v[98:99], v12, s[24:27], s47 offen offset:384 sc0 sc1
  v_mfma_f32_16x16x32_bf16 v[68:71], v[16:19], a[28:31], v[172:175]
  v_add_u32 v9, s41, v7
  v_add_u32 v10, s41, v8
  v_mfma_f32_16x16x32_bf16 v[64:67], v[20:23], a[72:75], v[64:67]
  s_add_u32 s41, s41, 6144
  v_mfma_f32_16x16x32_bf16 v[68:71], v[20:23], a[76:79], v[68:71]
  s_cmp_eq_u32 s41, s43
  s_cselect_b32 s41, s32, s41
  v_mfma_f32_16x16x32_bf16 v[64:67], v[24:27], a[120:123], v[64:67]
  v_cvt_pk_bf16_f32 v90, v56, v60
  v_cvt_pk_bf16_f32 v96, v57, v61
  v_mfma_f32_16x16x32_bf16 v[68:71], v[24:27], a[124:127], v[68:71]
  v_cvt_pk_bf16_f32 v102, v58, v62
  v_cvt_pk_bf16_f32 v108, v59, v63
  v_mfma_f32_16x16x32_bf16 v[64:67], v[28:31], a[168:171], v[64:67]
  buffer_store_dwordx2 v[104:105], v12, s[24:27], s47 offen offset:768 sc0 sc1
  v_mfma_f32_16x16x32_bf16 v[68:71], v[28:31], a[172:175], v[68:71]
  v_mfma_f32_16x16x32_bf16 v[64:67], v[32:35], a[216:219], v[64:67]
  v_mfma_f32_16x16x32_bf16 v[68:71], v[32:35], a[220:223], v[68:71]
  v_mfma_f32_16x16x32_bf16 v[64:67], v[36:39], v[120:123], v[64:67]
  v_mfma_f32_16x16x32_bf16 v[68:71], v[36:39], v[124:127], v[68:71]
  v_mfma_f32_16x16x32_bf16 v[72:75], v[16:19], a[32:35], v[176:179]
  buffer_store_dwordx2 v[110:111], v12, s[24:27], s47 offen offset:1152 sc0 sc1
  v_mfma_f32_16x16x32_bf16 v[76:79], v[16:19], a[36:39], v[180:183]
  s_mov_b32 s47, s42
  s_add_u32 s39, s39, 1
  v_mfma_f32_16x16x32_bf16 v[72:75], v[20:23], a[80:83], v[72:75]
  s_add_u32 s42, s42, 6291456
  v_mfma_f32_16x16x32_bf16 v[76:79], v[20:23], a[84:87], v[76:79]
  v_cvt_pk_bf16_f32 v91, v64, v68
  v_cvt_pk_bf16_f32 v97, v65, v69
  v_mfma_f32_16x16x32_bf16 v[72:75], v[24:27], a[128:131], v[72:75]
  v_cvt_pk_bf16_f32 v103, v66, v70
  v_cvt_pk_bf16_f32 v109, v67, v71
  v_mfma_f32_16x16x32_bf16 v[76:79], v[24:27], a[132:135], v[76:79]
  v_mfma_f32_16x16x32_bf16 v[72:75], v[28:31], a[176:179], v[72:75]
  v_mfma_f32_16x16x32_bf16 v[76:79], v[28:31], a[180:183], v[76:79]
  v_mfma_f32_16x16x32_bf16 v[72:75], v[32:35], a[224:227], v[72:75]
  v_mfma_f32_16x16x32_bf16 v[76:79], v[32:35], a[228:231], v[76:79]
  v_mfma_f32_16x16x32_bf16 v[72:75], v[36:39], v[128:131], v[72:75]
  v_mfma_f32_16x16x32_bf16 v[76:79], v[36:39], v[132:135], v[76:79]
  s_waitcnt vmcnt(26)
  s_nop 0
  v_mfma_f32_16x16x32_bf16 v[80:83], v[16:19], a[40:43], v[184:187]
  v_mfma_f32_16x16x32_bf16 v[84:87], v[16:19], a[44:47], v[188:191]
  ds_read_b128 v[16:19], v9 offset:0
  v_mfma_f32_16x16x32_bf16 v[80:83], v[20:23], a[88:91], v[80:83]
  buffer_store_dwordx4 v[88:91], v11, s[24:27], s47 offen sc0 sc1
  v_mfma_f32_16x16x32_bf16 v[84:87], v[20:23], a[92:95], v[84:87]
  v_cvt_pk_bf16_f32 v92, v72, v76
  ds_read_b128 v[20:23], v10 offset:0
  v_mfma_f32_16x16x32_bf16 v[80:83], v[24:27], a[136:139], v[80:83]
  v_cvt_pk_bf16_f32 v98, v73, v77
  buffer_store_dwordx4 v[94:97], v11, s[24:27], s47 offen offset:384 sc0 sc1
  v_mfma_f32_16x16x32_bf16 v[84:87], v[24:27], a[140:143], v[84:87]
  v_cvt_pk_bf16_f32 v104, v74, v78
  ds_read_b128 v[24:27], v9 offset:128
  v_mfma_f32_16x16x32_bf16 v[80:83], v[28:31], a[184:187], v[80:83]
  v_cvt_pk_bf16_f32 v110, v75, v79
  v_mfma_f32_16x16x32_bf16 v[84:87], v[28:31], a[188:191], v[84:87]
  buffer_store_dwordx4 v[100:103], v11, s[24:27], s47 offen offset:768 sc0 sc1
  ds_read_b128 v[28:31], v10 offset:128
  v_mfma_f32_16x16x32_bf16 v[80:83], v[32:35], a[232:235], v[80:83]
  v_mfma_f32_16x16x32_bf16 v[84:87], v[32:35], a[236:239], v[84:87]
  ds_read_b128 v[32:35], v9 offset:256
  v_mfma_f32_16x16x32_bf16 v[80:83], v[36:39], v[136:139], v[80:83]
  buffer_store_dwordx4 v[106:109], v11, s[24:27], s47 offen offset:1152 sc0 sc1
  s_bitcmp1_b32 s91, s39
  s_nop 0
  v_mfma_f32_16x16x32_bf16 v[84:87], v[36:39], v[140:143], v[84:87]
  ds_read_b128 v[36:39], v10 offset:256
  s_cbranch_scc1 L_D
  s_bitcmp1_b32 s90, s39
  s_cbranch_scc1 L_N
L_nd:
  s_cmp_eq_u32 s99, 0
  s_cbranch_scc1 L_exit
  s_waitcnt vmcnt(8)
.p2align 3
L_Y:
  s_waitcnt vmcnt(14) lgkmcnt(3)
  v_readfirstlane_b32 s93, v15
  v_mfma_f32_16x16x32_bf16 v[40:43], v[16:19], a[0:3], v[144:147]
  s_and_b32 s96, s93, 0xffff
  v_mfma_f32_16x16x32_bf16 v[44:47], v[16:19], a[4:7], v[148:151]
  s_lshr_b32 s93, s93, 16
  s_add_u32 s97, s96, s93
  v_mfma_f32_16x16x32_bf16 v[40:43], v[20:23], a[48:51], v[40:43]
  s_sub_u32 s93, 63, s93
  s_cmp_eq_u32 s79, 0
  v_mfma_f32_16x16x32_bf16 v[44:47], v[20:23], a[52:55], v[44:47]
  v_cvt_pk_bf16_f32 v93, v80, v84
  v_cvt_pk_bf16_f32 v99, v81, v85
  v_mfma_f32_16x16x32_bf16 v[40:43], v[24:27], a[96:99], v[40:43]
  v_cvt_pk_bf16_f32 v105, v82, v86
  v_cvt_pk_bf16_f32 v111, v83, v87
  v_mfma_f32_16x16x32_bf16 v[44:47], v[24:27], a[100:103], v[44:47]
  s_waitcnt lgkmcnt(0)
  s_cselect_b32 s96, s96, s93
  v_mfma_f32_16x16x32_bf16 v[40:43], v[28:31], a[144:147], v[40:43]
  v_mfma_f32_16x16x32_bf16 v[44:47], v[28:31], a[148:151], v[44:47]
  s_mul_i32 s96, s96, 6144
  v_mfma_f32_16x16x32_bf16 v[40:43], v[32:35], a[192:195], v[40:43]
  s_add_u32 s96, s96, s89
  s_mov_b32 m0, s38
  v_mfma_f32_16x16x32_bf16 v[44:47], v[32:35], a[196:199], v[44:47]
  s_add_u32 s40, s38, 4096
  v_mfma_f32_16x16x32_bf16 v[40:43], v[36:39], a[240:243], v[40:43]
  v_mov_b32_e64 v15, s86
  v_mfma_f32_16x16x32_bf16 v[44:47], v[36:39], a[244:247], v[44:47]
  s_cmp_lt_u32 s97, 64
  s_cbranch_scc0 L_fail
  v_mfma_f32_16x16x32_bf16 v[48:51], v[16:19], a[8:11], v[152:155]
  buffer_atomic_add v15, v14, s[48:51], s88 offen sc0 sc1
  v_mfma_f32_16x16x32_bf16 v[52:55], v[16:19], a[12:15], v[156:159]
  buffer_load_dwordx4 v1, s[12:15], s96 offen nt lds
  v_mfma_f32_16x16x32_bf16 v[48:51], v[20:23], a[56:59], v[48:51]
  buffer_load_dwordx4 v2, s[12:15], s96 offen offset:1024 nt lds
  v_mfma_f32_16x16x32_bf16 v[52:55], v[20:23], a[60:63], v[52:55]
  v_cvt_pk_bf16_f32 v88, v40, v44
  buffer_load_dwordx4 v3, s[12:15], s96 offen offset:2048 nt lds
  v_mfma_f32_16x16x32_bf16 v[48:51], v[24:27], a[104:107], v[48:51]
  buffer_load_dwordx4 v4, s[12:15], s96 offen offset:3072 nt lds
  s_mov_b32 m0, s40
  s_nop 0
  v_mfma_f32_16x16x32_bf16 v[52:55], v[24:27], a[108:111], v[52:55]
  v_cvt_pk_bf16_f32 v94, v41, v45
  buffer_load_dwordx4 v5, s[12:15], s96 offen nt lds
  v_mfma_f32_16x16x32_bf16 v[48:51], v[28:31], a[152:155], v[48:51]
  v_cvt_pk_bf16_f32 v100, v42, v46
  buffer_load_dwordx4 v6, s[12:15], s96 offen offset:1024 nt lds
  v_mfma_f32_16x16x32_bf16 v[52:55], v[28:31], a[156:159], v[52:55]
  v_cvt_pk_bf16_f32 v106, v43, v47
  v_mfma_f32_16x16x32_bf16 v[48:51], v[32:35], a[200:203], v[48:51]
  s_add_u32 s38, s38, 6144
  v_mfma_f32_16x16x32_bf16 v[52:55], v[32:35], a[204:207], v[52:55]
  s_cmp_eq_u32 s38, s43
  s_cselect_b32 s38, s32, s38
  v_mfma_f32_16x16x32_bf16 v[48:51], v[36:39], a[248:251], v[48:51]
  v_add_u32 v9, s41, v7
  v_add_u32 v10, s41, v8
  v_mfma_f32_16x16x32_bf16 v[52:55], v[36:39], a[252:255], v[52:55]
  v_mfma_f32_16x16x32_bf16 v[56:59], v[16:19], a[16:19], v[160:163]
  v_mfma_f32_16x16x32_bf16 v[60:63], v[16:19], a[20:23], v[164:167]
  v_mfma_f32_16x16x32_bf16 v[56:59], v[20:23], a[64:67], v[56:59]
  v_mfma_f32_16x16x32_bf16 v[60:63], v[20:23], a[68:71], v[60:63]
  v_mfma_f32_16x16x32_bf16 v[56:59], v[24:27], a[112:115], v[56:59]
  v_mfma_f32_16x16x32_bf16 v[60:63], v[24:27], a[116:119], v[60:63]
  v_mfma_f32_16x16x32_bf16 v[56:59], v[28:31], a[160:163], v[56:59]
  buffer_store_dwordx2 v[92:93], v12, s[24:27], s47 offen sc0 sc1
  v_mfma_f32_16x16x32_bf16 v[60:63], v[28:31], a[164:167], v[60:63]
  v_cvt_pk_bf16_f32 v89, v48, v52
  v_cvt_pk_bf16_f32 v95, v49, v53
  v_mfma_f32_16x16x32_bf16 v[56:59], v[32:35], a[208:211], v[56:59]
  v_cvt_pk_bf16_f32 v101, v50, v54
  v_cvt_pk_bf16_f32 v107, v51, v55
  v_mfma_f32_16x16x32_bf16 v[60:63], v[32:35], a[212:215], v[60:63]
  v_mfma_f32_16x16x32_bf16 v[56:59], v[36:39], v[112:115], v[56:59]
  v_mfma_f32_16x16x32_bf16 v[60:63], v[36:39], v[116:119], v[60:63]
  v_mfma_f32_16x16x32_bf16 v[64:67], v[16:19], a[24:27], v[168:171]
  buffer_store_dwordx2 v[98:99], v12, s[24:27], s47 offen offset:384 sc0 sc1
  v_mfma_f32_16x16x32_bf16 v[68:71], v[16:19], a[28:31], v[172:175]
  s_add_u32 s41, s41, 6144
  v_mfma_f32_16x16x32_bf16 v[64:67], v[20:23], a[72:75], v[64:67]
  s_cmp_eq_u32 s41, s43
  s_cselect_b32 s41, s32, s41
  v_mfma_f32_16x16x32_bf16 v[68:71], v[20:23], a[76:79], v[68:71]
  v_cvt_pk_bf16_f32 v90, v56, v60
  v_cvt_pk_bf16_f32 v96, v57, v61
  v_mfma_f32_16x16x32_bf16 v[64:67], v[24:27], a[120:123], v[64:67]
  v_cvt_pk_bf16_f32 v102, v58, v62
  v_cvt_pk_bf16_f32 v108, v59, v63
  v_mfma_f32_16x16x32_bf16 v[68:71], v[24:27], a[124:127], v[68:71]
  v_mfma_f32_16x16x32_bf16 v[64:67], v[28:31], a[168:171], v[64:67]
  buffer_store_dwordx2 v[104:105], v12, s[24:27], s47 offen offset:768 sc0 sc1
  v_mfma_f32_16x16x32_bf16 v[68:71], v[28:31], a[172:175], v[68:71]
  v_mfma_f32_16x16x32_bf16 v[64:67], v[32:35], a[216:219], v[64:67]
  v_mfma_f32_16x16x32_bf16 v[68:71], v[32:35], a[220:223], v[68:71]
  v_mfma_f32_16x16x32_bf16 v[64:67], v[36:39], v[120:123], v[64:67]
  v_mfma_f32_16x16x32_bf16 v[68:71], v[36:39], v[124:127], v[68:71]
  v_mfma_f32_16x16x32_bf16 v[72:75], v[16:19], a[32:35], v[176:179]
  buffer_store_dwordx2 v[110:111], v12, s[24:27], s47 offen offset:1152 sc0 sc1
  v_mfma_f32_16x16x32_bf16 v[76:79], v[16:19], a[36:39], v[180:183]
  s_mov_b32 s47, s42
  s_mov_b32 s42, s96
  v_mfma_f32_16x16x32_bf16 v[72:75], v[20:23], a[80:83], v[72:75]
  v_mfma_f32_16x16x32_bf16 v[76:79], v[20:23], a[84:87], v[76:79]
  v_mfma_f32_16x16x32_bf16 v[72:75], v[24:27], a[128:131], v[72:75]
  v_cvt_pk_bf16_f32 v91, v64, v68
  v_cvt_pk_bf16_f32 v97, v65, v69
  v_mfma_f32_16x16x32_bf16 v[76:79], v[24:27], a[132:135], v[76:79]
  v_cvt_pk_bf16_f32 v103, v66, v70
  v_cvt_pk_bf16_f32 v109, v67, v71
  v_mfma_f32_16x16x32_bf16 v[72:75], v[28:31], a[176:179], v[72:75]
  v_mfma_f32_16x16x32_bf16 v[76:79], v[28:31], a[180:183], v[76:79]
  v_mfma_f32_16x16x32_bf16 v[72:75], v[32:35], a[224:227], v[72:75]
  v_mfma_f32_16x16x32_bf16 v[76:79], v[32:35], a[228:231], v[76:79]
  v_mfma_f32_16x16x32_bf16 v[72:75], v[36:39], v[128:131], v[72:75]
  v_mfma_f32_16x16x32_bf16 v[76:79], v[36:39], v[132:135], v[76:79]
  s_waitcnt vmcnt(4)
  s_nop 0
  v_mfma_f32_16x16x32_bf16 v[80:83], v[16:19], a[40:43], v[184:187]
  v_mfma_f32_16x16x32_bf16 v[84:87], v[16:19], a[44:47], v[188:191]
  ds_read_b128 v[16:19], v9 offset:0
  v_mfma_f32_16x16x32_bf16 v[80:83], v[20:23], a[88:91], v[80:83]
  buffer_store_dwordx4 v[88:91], v11, s[24:27], s47 offen sc0 sc1
  v_mfma_f32_16x16x32_bf16 v[84:87], v[20:23], a[92:95], v[84:87]
  v_cvt_pk_bf16_f32 v92, v72, v76
  ds_read_b128 v[20:23], v10 offset:0
  v_mfma_f32_16x16x32_bf16 v[80:83], v[24:27], a[136:139], v[80:83]
  v_cvt_pk_bf16_f32 v98, v73, v77
  buffer_store_dwordx4 v[94:97], v11, s[24:27], s47 offen offset:384 sc0 sc1
  v_mfma_f32_16x16x32_bf16 v[84:87], v[24:27], a[140:143], v[84:87]
  v_cvt_pk_bf16_f32 v104, v74, v78
  ds_read_b128 v[24:27], v9 offset:128
  v_mfma_f32_16x16x32_bf16 v[80:83], v[28:31], a[184:187], v[80:83]
  v_cvt_pk_bf16_f32 v110, v75, v79
  v_mfma_f32_16x16x32_bf16 v[84:87], v[28:31], a[188:191], v[84:87]
  buffer_store_dwordx4 v[100:103], v11, s[24:27], s47 offen offset:768 sc0 sc1
  ds_read_b128 v[28:31], v10 offset:128
  v_mfma_f32_16x16x32_bf16 v[80:83], v[32:35], a[232:235], v[80:83]
  v_mfma_f32_16x16x32_bf16 v[84:87], v[32:35], a[236:239], v[84:87]
  ds_read_b128 v[32:35], v9 offset:256
  v_mfma_f32_16x16x32_bf16 v[80:83], v[36:39], v[136:139], v[80:83]
  buffer_store_dwordx4 v[106:109], v11, s[24:27], s47 offen offset:1152 sc0 sc1
  v_mfma_f32_16x16x32_bf16 v[84:87], v[36:39], v[140:143], v[84:87]
  ds_read_b128 v[36:39], v10 offset:256
  s_branch L_Y
L_exit:
  s_nop 3
  v_cvt_pk_bf16_f32 v93, v80, v84
  v_cvt_pk_bf16_f32 v99, v81, v85
  v_cvt_pk_bf16_f32 v105, v82, v86
  v_cvt_pk_bf16_f32 v111, v83, v87
  buffer_store_dwordx2 v[92:93], v12, s[24:27], s47 offen sc0 sc1
  buffer_store_dwordx2 v[98:99], v12, s[24:27], s47 offen offset:384 sc0 sc1
  buffer_store_dwordx2 v[104:105], v12, s[24:27], s47 offen offset:768 sc0 sc1
  buffer_store_dwordx2 v[110:111], v12, s[24:27], s47 offen offset:1152 sc0 sc1
  s_mov_b32 s90, s39
L_end:
  s_endpgm
.section .rodata,"a"
.p2align 6
.amdhsa_kernel standalone__standard_2d_1d_3d_conv__vision_kernel
  .amdhsa_next_free_vgpr 512
  .amdhsa_next_free_sgpr 102
  .amdhsa_accum_offset 256
  .amdhsa_group_segment_fixed_size 0
  .amdhsa_kernarg_size 48
  .amdhsa_user_sgpr_count 2
  .amdhsa_user_sgpr_kernarg_segment_ptr 1
  .amdhsa_system_sgpr_workgroup_id_x 1
  .amdhsa_float_denorm_mode_32 3
  .amdhsa_float_denorm_mode_16_64 3
.end_amdhsa_kernel
```
